```python
import torch

def _softmax(x, axis=-1):
    return torch.softmax(x, dim=axis)
def _gelu(x):
    return torch.nn.functional.gelu(x, approximate="tanh")
def _silu(x):
    return torch.nn.functional.silu(x)
def _sigmoid(x):
    return torch.sigmoid(x)
def _layernorm(x, axis=-1, eps=1e-5):
    m = x.mean(dim=axis, keepdim=True)
    v = x.var(dim=axis, keepdim=True, unbiased=False)
    return (x - m) / torch.sqrt(v + eps)
def _scatter_add(tgt, idx, src, axis=0):
    return tgt.clone().index_add_(axis, idx, src)
def _segment_sum(src, seg, n):
    out = torch.zeros((n,) + src.shape[1:], dtype=src.dtype)
    return out.index_add_(0, seg, src)
def _pad(x, pw):
    flat = tuple(v for pair in reversed(pw) for v in pair)
    return torch.nn.functional.pad(x, flat)

kernel_name = 'gated_mix__sliding_block_cached__dense_activation_relu__decode'

def setup_inputs():

    _w = (lambda a: (lambda t: t.to(torch.bfloat16) if t.is_floating_point() else t)(torch.as_tensor(a)))
    def _A_setup():
        B, Sq, D = 4, 1, 640
        Hq, Hkv, Sk, Dh = 32, 32, 4096, 192
        assert Hq % Hkv == 0, (Hq, Hkv)
        return {
            "x": _w((lambda *s: torch.randn(*s, dtype=torch.bfloat16) * 0.05)(B, Sq, D)),
            "k_cache": _w((lambda *s: torch.randn(*s, dtype=torch.bfloat16) * 3.2)(B, Hkv, Sk, Dh)),
            "v_cache": _w((lambda *s: torch.randn(*s, dtype=torch.bfloat16) * 1.6)(B, Hkv, Sk, Dh)),
            "wq": _w((lambda *s: torch.randn(*s, dtype=torch.bfloat16) * 3.2)(D, Hq * Dh) * (D ** -0.5)),
            "wo": _w((lambda *s: torch.randn(*s, dtype=torch.bfloat16) * 1.6)(Hq * Dh, D) * ((Hq * Dh) ** -0.5)),
        }
    _A_in = _A_setup()

    def _B_setup():
        B, S, D, Dff = 4, 1, 640, 1536
        return {
            "x": _w((lambda *s: torch.randn(*s, dtype=torch.bfloat16) * 0.05)(B, S, D)),
            "w1": _w((lambda *s: torch.randn(*s, dtype=torch.bfloat16) * 0.05)(D, Dff)),
            "w2": _w((lambda *s: torch.randn(*s, dtype=torch.bfloat16) * 0.05)(Dff, D)),
        }
    _B_in = _B_setup()

    return {
        "A_x": _A_in["x"],
        "A_k_cache": _A_in["k_cache"],
        "A_v_cache": _A_in["v_cache"],
        "A_wq": _A_in["wq"],
        "A_wo": _A_in["wo"],
        "B_x": _B_in["x"],
        "B_w1": _B_in["w1"],
        "B_w2": _B_in["w2"],
        "gate_w": _w((lambda *s: torch.randn(*s, dtype=torch.bfloat16) * 0.05)(640) * 16.0),
    }

def reference(A_x, A_k_cache, A_v_cache, A_wq, A_wo, B_x, B_w1, B_w2, gate_w):
    def _A_ref(x, k_cache, v_cache, wq, wo):
        B, Sq, D = x.shape
        Hq, Dh = 32, 192
        Hkv, Sk = k_cache.shape[1], k_cache.shape[2]
        W = min(4096, max(256, Sk // 4))
        rep = Hq // Hkv
        q = (lambda x, *d: x.permute(*d))((x @ wq).reshape(B, Sq, Hq, Dh), 0, 2, 1, 3)
        k = (lambda x, n, axis: torch.repeat_interleave(x, n, dim=axis))(k_cache[:, :, Sk - W:, :], rep, axis=1)
        v = (lambda x, n, axis: torch.repeat_interleave(x, n, dim=axis))(v_cache[:, :, Sk - W:, :], rep, axis=1)
        scores = torch.einsum("bhqd,bhkd->bhqk", q, k) * (Dh ** -0.5)
        p = _softmax(scores, axis=-1)
        o = torch.einsum("bhqk,bhkd->bhqd", p, v)
        return (lambda x, *d: x.permute(*d))(o, 0, 2, 1, 3).reshape(B, Sq, Hq * Dh) @ wo

    def _B_ref(x, w1, w2):
        h = torch.einsum("bsd,df->bsf", x, w1)
        zero = torch.zeros_like(h)
        h = torch.maximum(h, zero)
        return torch.einsum("bsf,fd->bsd", h, w2)

    x = A_x
    g = _sigmoid((x * gate_w).sum(-1, keepdims=True))
    a = _A_ref(x, A_k_cache, A_v_cache, A_wq, A_wo)
    b = _B_ref(x, B_w1, B_w2)
    return g * a + (1 - g) * b
```

```asm
; @launch grid=(256,1,1) block=(512,1,1) lds=39680
.amdgcn_target "amdgcn-amd-amdhsa--gfx950"
.text
.globl gated_mix__sliding_block_cached__dense_activation_relu__decode_kernel
.p2align 8
.type gated_mix__sliding_block_cached__dense_activation_relu__decode_kernel,@function
gated_mix__sliding_block_cached__dense_activation_relu__decode_kernel:
    s_cmp_ge_u32 s2, 256
    s_cbranch_scc1 L_end
    s_lshr_b32 s8, s2, 2
    s_cmp_lt_u32 s8, 48
    s_cselect_b32 s11, 24, 48
    s_load_dwordx2 s[36:37], s[0:1], s11
    s_load_dwordx2 s[48:49], s[0:1], 0
    s_load_dwordx2 s[28:29], s[0:1], 8
    s_cselect_b32 s75, 4, 1
    s_cselect_b32 s12, 0, 48
    s_mul_i32 s38, s75, 1966080
    s_mul_i32 s75, s75, 3072
    s_sub_u32 s12, s8, s12
    s_lshl_b32 s12, s12, 8
    v_lshrrev_b32 v15, 6, v0
    v_and_b32 v1, 63, v0
    v_readfirstlane_b32 s3, v15
    s_cmp_lt_u32 s2, 240
    s_cselect_b32 s38, s38, 0
    s_cselect_b32 s42, 7864320, 0
    s_cselect_b32 s46, 1966080, 0
    s_cselect_b32 s70, 2097152, 0
    s_mov_b32 s30, 201326592
    s_mov_b32 s34, 201326592
    s_mov_b32 s50, 5120
    s_mov_b32 s54, 1280
    s_mov_b32 s58, 5120
    s_mov_b32 s66, 2097152
    s_mov_b32 s31, 0x00020000
    s_mov_b32 s35, 0x00020000
    s_mov_b32 s39, 0x00020000
    s_mov_b32 s43, 0x00020000
    s_mov_b32 s47, 0x00020000
    s_mov_b32 s51, 0x00020000
    s_mov_b32 s55, 0x00020000
    s_mov_b32 s59, 0x00020000
    s_mov_b32 s67, 0x00020000
    s_mov_b32 s71, 0x00020000
    s_and_b32 s7, s2, 3
    s_mul_i32 s13, s7, 160
    s_mul_i32 s14, s3, 20
    s_add_u32 s13, s13, s14
    s_lshl_b32 s78, s13, 1
    s_mul_i32 s73, s13, s75
    s_add_u32 s73, s73, s12
    s_lshl_b32 s74, s75, 2
    v_lshrrev_b32 v16, 4, v1
    v_and_b32 v17, 15, v1
    v_lshlrev_b32 v17, 4, v17
    v_mad_u32_u24 v3, v16, s75, v17
    v_bfe_u32 v18, v1, 2, 2
    v_mul_u32_u24 v6, 1280, v18
    v_lshl_add_u32 v6, v16, 1, v6
    s_lshr_b32 s6, s2, 7
    s_and_b32 s5, s2, 7
    s_lshl_b32 s5, s5, 2
    s_bfe_u32 s13, s2, 0x20003
    s_add_u32 s5, s5, s13
    s_bfe_u32 s4, s2, 0x20005
    s_lshl_b32 s13, s4, 5
    s_add_u32 s13, s13, s5
    s_lshl_b32 s13, s13, 12
    s_lshl_b32 s14, s6, 9
    s_add_u32 s13, s13, s14
    s_lshl_b32 s14, s3, 6
    s_add_u32 s13, s13, s14
    s_add_u32 s13, s13, 3072
    s_mul_i32 s72, s13, 384
    v_lshrrev_b32 v20, 3, v1
    v_and_b32 v19, 7, v1
    v_lshlrev_b32 v19, 4, v19
    v_mul_u32_u24 v2, 384, v20
    v_add_u32 v2, v2, v19
    s_mov_b32 s84, 36352
    v_add_u32 v12, 36352, v19
    v_mul_u32_u24 v5, 1280, v16
    v_add_u32 v5, v5, v17
    v_and_b32 v19, 3, v1
    v_mul_u32_u24 v10, 122880, v19
    v_mul_u32_u24 v17, 30720, v18
    v_add_u32 v10, v10, v17
    v_lshl_add_u32 v10, v16, 2, v10
    v_and_b32 v17, 1, v19
    v_mul_u32_u24 v11, 98304, v17
    v_lshl_add_u32 v11, v18, 6, v11
    v_lshl_add_u32 v11, v16, 4, v11
    v_lshl_add_u32 v21, v17, 2, v18
    v_lshlrev_b32 v21, 4, v21
    v_lshlrev_b32 v17, 4, v17
    v_mov_b32 v15, 0xffff
    v_lshlrev_b32 v15, v17, v15
    v_cmp_gt_u32 vcc, 2, v19
    s_nop 1
    v_cndmask_b32 v7, 0, v15, vcc
    v_cndmask_b32 v8, v15, 0, vcc
    v_lshlrev_b32 v14, 2, v18
    v_add_u32 v14, 39424, v14
    v_lshlrev_b32 v13, 6, v16
    v_lshl_add_u32 v13, v19, 4, v13
    s_mul_i32 s13, s3, 2368
    s_add_u32 s13, s13, 17408
    v_add_u32 v13, s13, v13
    s_mul_i32 s13, s3, 2176
    v_lshlrev_b32 v9, 2, v1
    v_add_u32 v9, s13, v9
    s_waitcnt lgkmcnt(0)
    buffer_load_ushort v15, v6, s[48:51], s78 offen offset:0
    buffer_load_ushort v16, v6, s[48:51], s78 offen offset:8
    buffer_load_ushort v17, v6, s[48:51], s78 offen offset:16
    buffer_load_ushort v18, v6, s[48:51], s78 offen offset:24
    buffer_load_ushort v19, v6, s[48:51], s78 offen offset:32
    buffer_load_dwordx4 v[96:99], v3, s[36:39], s73 offen nt
    s_add_u32 s90, s73, s74
    buffer_load_dwordx4 v[100:103], v3, s[36:39], s90 offen nt
    s_add_u32 s90, s90, s74
    buffer_load_dwordx4 v[104:107], v3, s[36:39], s90 offen nt
    s_add_u32 s90, s90, s74
    buffer_load_dwordx4 v[108:111], v3, s[36:39], s90 offen nt
    s_add_u32 s90, s90, s74
    buffer_load_dwordx4 v[112:115], v3, s[36:39], s90 offen nt
    s_load_dwordx2 s[64:65], s[0:1], 88
    s_load_dwordx2 s[68:69], s[0:1], 88
    s_load_dwordx2 s[32:33], s[0:1], 16
    s_load_dwordx2 s[40:41], s[0:1], 32
    s_load_dwordx2 s[44:45], s[0:1], 56
    s_load_dwordx2 s[52:53], s[0:1], 64
    s_load_dwordx2 s[56:57], s[0:1], 72
    v_mov_b32 v0, 0xffffff00
    s_lshr_b32 s14, s2, 3
    s_mul_i32 s9, s14, 205
    s_lshr_b32 s9, s9, 10
    s_mul_i32 s13, s9, 5
    s_sub_u32 s10, s14, s13
    s_and_b32 s13, s2, 7
    s_mul_i32 s13, s13, 6
    s_add_u32 s9, s9, s13
    s_lshl_b32 s11, s9, 3
    s_add_u32 s11, s11, s3
    s_lshl_b32 s12, s10, 8
    s_mul_i32 s77, s11, 5120
    s_add_u32 s77, s77, s12
    s_lshl_b32 s22, s11, 8
    s_add_u32 s22, s22, 589824
    s_lshl_b32 s21, s11, 4
    s_add_u32 s21, s21, 24576
    s_mul_i32 s24, s11, 43691
    s_lshr_b32 s24, s24, 19
    s_mul_i32 s13, s24, 12
    s_sub_u32 s13, s11, s13
    s_mul_i32 s76, s24, 192
    s_lshr_b32 s14, s13, 1
    s_lshl_b32 s14, s14, 5
    s_add_u32 s76, s76, s14
    s_and_b32 s14, s13, 1
    s_lshl_b32 s14, s14, 2
    s_add_u32 s76, s76, s14
    s_mul_i32 s76, s76, 1280
    s_add_u32 s76, s76, s12
    s_lshl_b32 s24, s24, 7
    s_add_u32 s24, s24, 524288
    s_mul_i32 s17, s6, 98304
    s_lshl_b32 s11, s4, 6
    s_add_u32 s17, s17, s11
    s_mul_i32 s11, s5, 3072
    s_add_u32 s17, s17, s11
    s_add_u32 s17, s17, 589824
    s_lshl_b32 s18, s5, 1
    s_add_u32 s18, s18, s6
    s_lshl_b32 s18, s18, 2
    s_add_u32 s18, s18, s4
    s_lshl_b32 s18, s18, 4
    s_add_u32 s18, s18, 524288
    s_mul_i32 s19, s7, 122880
    s_lshl_b32 s11, s8, 9
    s_add_u32 s19, s19, s11
    s_mul_i32 s20, s9, 10240
    s_lshl_b32 s11, s10, 9
    s_add_u32 s20, s20, s11
    s_add_u32 s20, s20, 1441792
    s_mul_i32 s23, s4, 30720
    s_mul_i32 s11, s5, 768
    s_add_u32 s23, s23, s11
    s_mov_b32 s16, 0x3dd53b95
    s_mov_b32 s88, 0x000f000f
    s_mov_b32 s89, 0x00f000f0
    s_waitcnt lgkmcnt(0)
    s_load_dword s91, s[64:65], 520192
    s_waitcnt vmcnt(5)
    v_lshl_or_b32 v15, v15, 16, v15
    v_lshl_or_b32 v16, v16, 16, v16
    v_lshl_or_b32 v17, v17, 16, v17
    v_lshl_or_b32 v18, v18, 16, v18
    v_lshl_or_b32 v19, v19, 16, v19
    v_and_b32 v40, v15, v7
    v_and_b32 v41, v15, v8
    v_and_b32 v42, v16, v7
    v_and_b32 v43, v16, v8
    v_and_b32 v44, v17, v7
    v_and_b32 v45, v17, v8
    v_and_b32 v46, v18, v7
    v_and_b32 v47, v18, v8
    v_and_b32 v48, v19, v7
    v_and_b32 v49, v19, v8
    v_mov_b32 v6, v21
    s_waitcnt vmcnt(4)
    buffer_load_dwordx4 v[116:119], v2, s[28:31], s72 offen offset:0 nt
    buffer_load_dwordx4 v[120:123], v2, s[28:31], s72 offen offset:128 nt
    buffer_load_dwordx4 v[124:127], v2, s[28:31], s72 offen offset:256 nt
    buffer_load_dwordx4 v[128:131], v2, s[28:31], s72 offen offset:3072 nt
    buffer_load_dwordx4 v[132:135], v2, s[28:31], s72 offen offset:3200 nt
    buffer_load_dwordx4 v[136:139], v2, s[28:31], s72 offen offset:3328 nt
    s_add_u32 s90, s72, 6144
    buffer_load_dwordx4 v[140:143], v2, s[28:31], s90 offen offset:0 nt
    s_add_u32 s90, s72, 6144
    buffer_load_dwordx4 v[144:147], v2, s[28:31], s90 offen offset:128 nt
    v_mfma_f32_16x16x16_bf16 v[80:83], v[96:97], v[40:41], 0
    v_mfma_f32_16x16x16_bf16 v[84:87], v[98:99], v[40:41], 0
    s_waitcnt vmcnt(11)
    s_add_u32 s90, s72, 6144
    buffer_load_dwordx4 v[148:151], v2, s[28:31], s90 offen offset:256 nt
    v_mfma_f32_16x16x16_bf16 v[80:83], v[100:101], v[42:43], v[80:83]
    v_mfma_f32_16x16x16_bf16 v[84:87], v[102:103], v[42:43], v[84:87]
    s_waitcnt vmcnt(11)
    s_add_u32 s90, s72, 6144
    buffer_load_dwordx4 v[152:155], v2, s[28:31], s90 offen offset:3072 nt
    v_mfma_f32_16x16x16_bf16 v[80:83], v[104:105], v[44:45], v[80:83]
    v_mfma_f32_16x16x16_bf16 v[84:87], v[106:107], v[44:45], v[84:87]
    s_waitcnt vmcnt(11)
    s_add_u32 s90, s72, 6144
    buffer_load_dwordx4 v[156:159], v2, s[28:31], s90 offen offset:3200 nt
    v_mfma_f32_16x16x16_bf16 v[80:83], v[108:109], v[46:47], v[80:83]
    v_mfma_f32_16x16x16_bf16 v[84:87], v[110:111], v[46:47], v[84:87]
    s_waitcnt vmcnt(11)
    s_add_u32 s90, s72, 6144
    buffer_load_dwordx4 v[160:163], v2, s[28:31], s90 offen offset:3328 nt
    v_mfma_f32_16x16x16_bf16 v[80:83], v[112:113], v[48:49], v[80:83]
    v_mfma_f32_16x16x16_bf16 v[84:87], v[114:115], v[48:49], v[84:87]
    s_nop 6
    ds_write_b32 v9, v80 offset:0
    ds_write_b32 v9, v81 offset:272
    ds_write_b32 v9, v82 offset:544
    ds_write_b32 v9, v83 offset:816
    ds_write_b32 v9, v84 offset:1088
    ds_write_b32 v9, v85 offset:1360
    ds_write_b32 v9, v86 offset:1632
    ds_write_b32 v9, v87 offset:1904
    s_waitcnt lgkmcnt(0)
    s_add_u32 s95, s91, 1
    s_and_b32 s94, s95, 0xff
    s_barrier
    s_cmp_gt_u32 s3, 3
    s_cbranch_scc1 L_noqp_1
    v_bfe_u32 v89, v1, 1, 1
    v_lshlrev_b32 v89, 2, v89
    v_bfe_u32 v88, v1, 2, 2
    v_add_u32 v89, v89, v88
    v_mul_u32_u24 v88, 272, v89
    v_lshrrev_b32 v89, 4, v1
    v_lshl_add_u32 v88, v89, 6, v88
    v_and_b32 v89, 1, v1
    v_mul_u32_u24 v92, 8704, v89
    s_lshl_b32 s11, s3, 4
    v_add3_u32 v88, v88, v92, s11
    v_lshrrev_b32 v92, 1, v1
    v_lshlrev_b32 v92, 4, v92
    s_mul_i32 s11, s3, 30720
    s_add_u32 s11, s11, s19
    ds_read_b128 v[56:59], v88 offset:0
    ds_read_b128 v[60:63], v88 offset:2176
    ds_read_b128 v[64:67], v88 offset:4352
    ds_read_b128 v[68:71], v88 offset:6528
    s_waitcnt lgkmcnt(2)
    v_add_f32 v56, v56, v60
    v_add_f32 v57, v57, v61
    v_add_f32 v58, v58, v62
    v_add_f32 v59, v59, v63
    s_waitcnt lgkmcnt(0)
    v_add_f32 v64, v64, v68
    v_add_f32 v65, v65, v69
    v_add_f32 v66, v66, v70
    v_add_f32 v67, v67, v71
    v_add_f32 v56, v56, v64
    v_add_f32 v57, v57, v65
    v_add_f32 v58, v58, v66
    v_add_f32 v59, v59, v67
    v_add_f32_dpp v56, v56, v56 quad_perm:[1,0,3,2] row_mask:0xf bank_mask:0xf
    v_add_f32_dpp v57, v57, v57 quad_perm:[1,0,3,2] row_mask:0xf bank_mask:0xf
    v_add_f32_dpp v58, v58, v58 quad_perm:[1,0,3,2] row_mask:0xf bank_mask:0xf
    v_add_f32_dpp v59, v59, v59 quad_perm:[1,0,3,2] row_mask:0xf bank_mask:0xf
    v_and_or_b32 v56, v56, v0, s94
    v_and_or_b32 v57, v57, v0, s94
    v_and_or_b32 v58, v58, v0, s94
    v_and_or_b32 v59, v59, v0, s94
    s_mov_b32 exec_lo, 0x55555555
    s_mov_b32 exec_hi, 0x55555555
    buffer_store_dwordx4 v[56:59], v92, s[68:71], s11 offen sc1
    s_mov_b64 exec, -1
    s_nop 1
L_noqp_1:
    s_cmp_lg_u32 s3, 4
    s_cbranch_scc1 L_skip_2
    v_and_b32 v88, 15, v1
    v_mul_u32_u24 v88, 80, v88
    v_lshrrev_b32 v89, 4, v1
    v_mul_u32_u24 v89, 1280, v89
    v_add_u32 v89, v89, v88
    buffer_load_dwordx4 v[40:43], v89, s[48:51], 0 offen offset:0
    buffer_load_dwordx4 v[60:63], v88, s[52:55], 0 offen offset:0
    buffer_load_dwordx4 v[44:47], v89, s[48:51], 0 offen offset:16
    buffer_load_dwordx4 v[64:67], v88, s[52:55], 0 offen offset:16
    buffer_load_dwordx4 v[48:51], v89, s[48:51], 0 offen offset:32
    buffer_load_dwordx4 v[68:71], v88, s[52:55], 0 offen offset:32
    buffer_load_dwordx4 v[52:55], v89, s[48:51], 0 offen offset:48
    buffer_load_dwordx4 v[72:75], v88, s[52:55], 0 offen offset:48
    buffer_load_dwordx4 v[56:59], v89, s[48:51], 0 offen offset:64
    buffer_load_dwordx4 v[76:79], v88, s[52:55], 0 offen offset:64
L_skip_2:
    s_waitcnt vmcnt(11)
    s_add_u32 s90, s72, 12288
    buffer_load_dwordx4 v[96:99], v2, s[28:31], s90 offen offset:0 nt
    s_waitcnt vmcnt(11)
    s_add_u32 s90, s72, 12288
    buffer_load_dwordx4 v[100:103], v2, s[28:31], s90 offen offset:128 nt
    s_waitcnt vmcnt(11)
    s_add_u32 s90, s72, 12288
    buffer_load_dwordx4 v[104:107], v2, s[28:31], s90 offen offset:256 nt
    s_waitcnt vmcnt(11)
    s_add_u32 s90, s72, 12288
    buffer_load_dwordx4 v[108:111], v2, s[28:31], s90 offen offset:3072 nt
    s_waitcnt vmcnt(11)
    s_add_u32 s90, s72, 12288
    buffer_load_dwordx4 v[112:115], v2, s[28:31], s90 offen offset:3200 nt
    s_waitcnt vmcnt(11)
    s_add_u32 s90, s72, 12288
    buffer_load_dwordx4 v[164:167], v2, s[28:31], s90 offen offset:3328 nt
    s_waitcnt vmcnt(11)
    s_add_u32 s90, s72, 18432
    buffer_load_dwordx4 v[168:171], v2, s[28:31], s90 offen offset:0 nt
    s_waitcnt vmcnt(11)
    s_add_u32 s90, s72, 18432
    buffer_load_dwordx4 v[172:175], v2, s[28:31], s90 offen offset:128 nt
    s_waitcnt vmcnt(11)
    s_add_u32 s90, s72, 18432
    buffer_load_dwordx4 v[176:179], v2, s[28:31], s90 offen offset:256 nt
    s_waitcnt vmcnt(11)
    s_add_u32 s90, s72, 18432
    buffer_load_dwordx4 v[180:183], v2, s[28:31], s90 offen offset:3072 nt
    s_waitcnt vmcnt(11)
    s_add_u32 s90, s72, 18432
    buffer_load_dwordx4 v[184:187], v2, s[28:31], s90 offen offset:3200 nt
    s_waitcnt vmcnt(11)
    s_add_u32 s90, s72, 18432
    buffer_load_dwordx4 v[188:191], v2, s[28:31], s90 offen offset:3328 nt
    s_cmp_lg_u32 s3, 4
    s_cbranch_scc1 L_skip_3
    s_waitcnt vmcnt(12)
    v_dot2_f32_bf16 v88, v40, v60, 0
    v_dot2_f32_bf16 v88, v41, v61, v88
    v_dot2_f32_bf16 v88, v42, v62, v88
    v_dot2_f32_bf16 v88, v43, v63, v88
    v_dot2_f32_bf16 v88, v44, v64, v88
    v_dot2_f32_bf16 v88, v45, v65, v88
    v_dot2_f32_bf16 v88, v46, v66, v88
    v_dot2_f32_bf16 v88, v47, v67, v88
    v_dot2_f32_bf16 v88, v48, v68, v88
    v_dot2_f32_bf16 v88, v49, v69, v88
    v_dot2_f32_bf16 v88, v50, v70, v88
    v_dot2_f32_bf16 v88, v51, v71, v88
    v_dot2_f32_bf16 v88, v52, v72, v88
    v_dot2_f32_bf16 v88, v53, v73, v88
    v_dot2_f32_bf16 v88, v54, v74, v88
    v_dot2_f32_bf16 v88, v55, v75, v88
    v_dot2_f32_bf16 v88, v56, v76, v88
    v_dot2_f32_bf16 v88, v57, v77, v88
    v_dot2_f32_bf16 v88, v58, v78, v88
    v_dot2_f32_bf16 v88, v59, v79, v88
    s_nop 2
    v_add_f32_dpp v88, v88, v88 row_ror:8 row_mask:0xf bank_mask:0xf
    s_nop 1
    v_add_f32_dpp v88, v88, v88 row_ror:4 row_mask:0xf bank_mask:0xf
    s_nop 1
    v_add_f32_dpp v88, v88, v88 row_ror:2 row_mask:0xf bank_mask:0xf
    s_nop 1
    v_add_f32_dpp v88, v88, v88 row_ror:1 row_mask:0xf bank_mask:0xf
    v_mul_f32 v88, 0xbfb8aa3b, v88
    v_exp_f32 v88, v88
    s_nop 0
    v_add_f32 v88, 1.0, v88
    v_rcp_f32 v88, v88
    v_lshrrev_b32 v89, 4, v1
    v_lshlrev_b32 v89, 2, v89
    ds_write_b32 v89, v88 offset:39424
L_skip_3:
    v_min_u32 v72, 47, v1
    v_lshlrev_b32 v72, 4, v72
    s_barrier
    s_cmp_lg_u32 s3, 0
    s_cbranch_scc1 L_open_29
    buffer_load_dwordx4 v[56:59], v72, s[64:67], s23 offen sc1
    s_add_u32 s11, s23, 122880
    buffer_load_dwordx4 v[60:63], v72, s[64:67], s11 offen sc1
    s_add_u32 s11, s23, 245760
    buffer_load_dwordx4 v[64:67], v72, s[64:67], s11 offen sc1
    s_add_u32 s11, s23, 368640
    buffer_load_dwordx4 v[68:71], v72, s[64:67], s11 offen sc1
    s_waitcnt vmcnt(15)
    buffer_load_dwordx4 v[192:195], v2, s[32:35], s72 offen offset:0 nt
    s_waitcnt vmcnt(15)
    buffer_load_dwordx4 v[196:199], v2, s[32:35], s72 offen offset:128 nt
    s_waitcnt vmcnt(15)
    buffer_load_dwordx4 v[200:203], v2, s[32:35], s72 offen offset:256 nt
    s_waitcnt vmcnt(15)
    buffer_load_dwordx4 v[204:207], v2, s[32:35], s72 offen offset:3072 nt
    s_waitcnt vmcnt(15)
    buffer_load_dwordx4 v[208:211], v2, s[32:35], s72 offen offset:3200 nt
    s_waitcnt vmcnt(15)
    buffer_load_dwordx4 v[212:215], v2, s[32:35], s72 offen offset:3328 nt
    s_waitcnt vmcnt(15)
    s_add_u32 s90, s72, 6144
    buffer_load_dwordx4 v[216:219], v2, s[32:35], s90 offen offset:0 nt
    s_waitcnt vmcnt(15)
    s_add_u32 s90, s72, 6144
    buffer_load_dwordx4 v[220:223], v2, s[32:35], s90 offen offset:128 nt
    s_waitcnt vmcnt(15)
    s_add_u32 s90, s72, 6144
    buffer_load_dwordx4 v[224:227], v2, s[32:35], s90 offen offset:256 nt
    s_waitcnt vmcnt(15)
    s_add_u32 s90, s72, 6144
    buffer_load_dwordx4 v[228:231], v2, s[32:35], s90 offen offset:3072 nt
    s_waitcnt vmcnt(15)
    s_add_u32 s90, s72, 6144
    buffer_load_dwordx4 v[232:235], v2, s[32:35], s90 offen offset:3200 nt
    s_waitcnt vmcnt(15)
    s_add_u32 s90, s72, 6144
    buffer_load_dwordx4 v[236:239], v2, s[32:35], s90 offen offset:3328 nt
    s_waitcnt vmcnt(12)
    v_xor_b32 v73, s94, v56
    v_xor_b32 v74, s94, v57
    v_xor_b32 v75, s94, v58
    v_or3_b32 v73, v73, v74, v75
    v_xor_b32 v74, s94, v59
    v_xor_b32 v75, s94, v60
    v_or3_b32 v73, v73, v74, v75
    v_xor_b32 v74, s94, v61
    v_xor_b32 v75, s94, v62
    v_or3_b32 v73, v73, v74, v75
    v_xor_b32 v74, s94, v63
    v_xor_b32 v75, s94, v64
    v_or3_b32 v73, v73, v74, v75
    v_xor_b32 v74, s94, v65
    v_xor_b32 v75, s94, v66
    v_or3_b32 v73, v73, v74, v75
    v_xor_b32 v74, s94, v67
    v_xor_b32 v75, s94, v68
    v_or3_b32 v73, v73, v74, v75
    v_xor_b32 v74, s94, v69
    v_xor_b32 v75, s94, v70
    v_or3_b32 v73, v73, v74, v75
    v_xor_b32 v74, s94, v71
    v_or_b32 v73, v73, v74
    v_and_b32 v73, 0xff, v73
    v_cmp_ne_u32 vcc, 0, v73
    s_nop 0
    s_cbranch_vccnz L_regather_4
    v_add_f32 v56, v56, v60
    v_add_f32 v64, v64, v68
    v_add_f32 v57, v57, v61
    v_add_f32 v65, v65, v69
    v_add_f32 v58, v58, v62
    v_add_f32 v66, v66, v70
    v_add_f32 v59, v59, v63
    v_add_f32 v67, v67, v71
    v_add_f32 v56, v56, v64
    v_add_f32 v57, v57, v65
    v_add_f32 v58, v58, v66
    v_add_f32 v59, v59, v67
    v_cvt_pk_bf16_f32 v60, v56, v57
    v_cvt_pk_bf16_f32 v61, v58, v59
    v_lshrrev_b32 v73, 1, v72
    v_add_u32 v73, s84, v73
    ds_write_b64 v73, v[60:61]
    s_branch L_open_41
L_regather_4:
    s_nop 0
    buffer_load_dwordx4 v[56:59], v72, s[64:67], s23 offen sc1
    s_add_u32 s11, s23, 122880
    buffer_load_dwordx4 v[60:63], v72, s[64:67], s11 offen sc1
    s_add_u32 s11, s23, 245760
    buffer_load_dwordx4 v[64:67], v72, s[64:67], s11 offen sc1
    s_add_u32 s11, s23, 368640
    buffer_load_dwordx4 v[68:71], v72, s[64:67], s11 offen sc1
    s_mov_b32 s15, 400000
L_qpoll_5:
    s_waitcnt vmcnt(0)
    v_xor_b32 v73, s94, v56
    v_xor_b32 v74, s94, v57
    v_xor_b32 v75, s94, v58
    v_or3_b32 v73, v73, v74, v75
    v_xor_b32 v74, s94, v59
    v_xor_b32 v75, s94, v60
    v_or3_b32 v73, v73, v74, v75
    v_xor_b32 v74, s94, v61
    v_xor_b32 v75, s94, v62
    v_or3_b32 v73, v73, v74, v75
    v_xor_b32 v74, s94, v63
    v_xor_b32 v75, s94, v64
    v_or3_b32 v73, v73, v74, v75
    v_xor_b32 v74, s94, v65
    v_xor_b32 v75, s94, v66
    v_or3_b32 v73, v73, v74, v75
    v_xor_b32 v74, s94, v67
    v_xor_b32 v75, s94, v68
    v_or3_b32 v73, v73, v74, v75
    v_xor_b32 v74, s94, v69
    v_xor_b32 v75, s94, v70
    v_or3_b32 v73, v73, v74, v75
    v_xor_b32 v74, s94, v71
    v_or_b32 v73, v73, v74
    v_and_b32 v73, 0xff, v73
    v_cmp_ne_u32 vcc, 0, v73
    s_nop 0
    s_cbranch_vccz L_qok_6
    s_sub_u32 s15, s15, 1
    s_cbranch_scc1 L_qok_6
    s_sleep 4
    buffer_load_dwordx4 v[56:59], v72, s[64:67], s23 offen sc1
    s_add_u32 s11, s23, 122880
    buffer_load_dwordx4 v[60:63], v72, s[64:67], s11 offen sc1
    s_add_u32 s11, s23, 245760
    buffer_load_dwordx4 v[64:67], v72, s[64:67], s11 offen sc1
    s_add_u32 s11, s23, 368640
    buffer_load_dwordx4 v[68:71], v72, s[64:67], s11 offen sc1
    s_branch L_qpoll_5
L_qok_6:
    v_add_f32 v56, v56, v60
    v_add_f32 v64, v64, v68
    v_add_f32 v57, v57, v61
    v_add_f32 v65, v65, v69
    v_add_f32 v58, v58, v62
    v_add_f32 v66, v66, v70
    v_add_f32 v59, v59, v63
    v_add_f32 v67, v67, v71
    v_add_f32 v56, v56, v64
    v_add_f32 v57, v57, v65
    v_add_f32 v58, v58, v66
    v_add_f32 v59, v59, v67
    v_cvt_pk_bf16_f32 v60, v56, v57
    v_cvt_pk_bf16_f32 v61, v58, v59
    v_lshrrev_b32 v73, 1, v72
    v_add_u32 v73, s84, v73
    ds_write_b64 v73, v[60:61]
    s_branch L_open_41
    s_nop 0
L_open_29:
    s_waitcnt vmcnt(11)
    buffer_load_dwordx4 v[192:195], v2, s[32:35], s72 offen offset:0 nt
L_open_30:
    s_waitcnt vmcnt(11)
    buffer_load_dwordx4 v[196:199], v2, s[32:35], s72 offen offset:128 nt
L_open_31:
    s_waitcnt vmcnt(11)
    buffer_load_dwordx4 v[200:203], v2, s[32:35], s72 offen offset:256 nt
L_open_32:
    s_waitcnt vmcnt(11)
    buffer_load_dwordx4 v[204:207], v2, s[32:35], s72 offen offset:3072 nt
L_open_33:
    s_waitcnt vmcnt(11)
    buffer_load_dwordx4 v[208:211], v2, s[32:35], s72 offen offset:3200 nt
L_open_34:
    s_waitcnt vmcnt(11)
    buffer_load_dwordx4 v[212:215], v2, s[32:35], s72 offen offset:3328 nt
L_open_35:
    s_waitcnt vmcnt(11)
    s_add_u32 s90, s72, 6144
    buffer_load_dwordx4 v[216:219], v2, s[32:35], s90 offen offset:0 nt
L_open_36:
    s_waitcnt vmcnt(11)
    s_add_u32 s90, s72, 6144
    buffer_load_dwordx4 v[220:223], v2, s[32:35], s90 offen offset:128 nt
L_open_37:
    s_waitcnt vmcnt(11)
    s_add_u32 s90, s72, 6144
    buffer_load_dwordx4 v[224:227], v2, s[32:35], s90 offen offset:256 nt
L_open_38:
    s_waitcnt vmcnt(11)
    s_add_u32 s90, s72, 6144
    buffer_load_dwordx4 v[228:231], v2, s[32:35], s90 offen offset:3072 nt
L_open_39:
    s_waitcnt vmcnt(11)
    s_add_u32 s90, s72, 6144
    buffer_load_dwordx4 v[232:235], v2, s[32:35], s90 offen offset:3200 nt
L_open_40:
    s_waitcnt vmcnt(11)
    s_add_u32 s90, s72, 6144
    buffer_load_dwordx4 v[236:239], v2, s[32:35], s90 offen offset:3328 nt
L_open_41:
    s_waitcnt lgkmcnt(0)
    s_barrier
    ds_read_b128 v[20:23], v12 offset:0
    ds_read_b128 v[24:27], v12 offset:128
    ds_read_b128 v[28:31], v12 offset:256
    buffer_load_dword v17, v10, s[68:71], s21 offen sc1
    s_waitcnt lgkmcnt(0)
    v_dot2_f32_bf16 v32, v116, v20, 0
    v_dot2_f32_bf16 v33, v128, v20, 0
    v_dot2_f32_bf16 v32, v117, v21, v32
    v_dot2_f32_bf16 v33, v129, v21, v33
    v_dot2_f32_bf16 v32, v118, v22, v32
    v_dot2_f32_bf16 v33, v130, v22, v33
    v_dot2_f32_bf16 v32, v119, v23, v32
    v_dot2_f32_bf16 v33, v131, v23, v33
    v_dot2_f32_bf16 v32, v120, v24, v32
    v_dot2_f32_bf16 v33, v132, v24, v33
    v_dot2_f32_bf16 v32, v121, v25, v32
    v_dot2_f32_bf16 v33, v133, v25, v33
    v_dot2_f32_bf16 v32, v122, v26, v32
    v_dot2_f32_bf16 v33, v134, v26, v33
    v_dot2_f32_bf16 v32, v123, v27, v32
    v_dot2_f32_bf16 v33, v135, v27, v33
    v_dot2_f32_bf16 v32, v124, v28, v32
    v_dot2_f32_bf16 v33, v136, v28, v33
    v_dot2_f32_bf16 v32, v125, v29, v32
    v_dot2_f32_bf16 v33, v137, v29, v33
    v_dot2_f32_bf16 v32, v126, v30, v32
    v_dot2_f32_bf16 v33, v138, v30, v33
    v_dot2_f32_bf16 v32, v127, v31, v32
    v_dot2_f32_bf16 v33, v139, v31, v33
    s_nop 1
    v_add_f32_dpp v32, v32, v32 quad_perm:[1,0,3,2] row_mask:0xf bank_mask:0xf
    v_add_f32_dpp v33, v33, v33 quad_perm:[1,0,3,2] row_mask:0xf bank_mask:0xf
    s_nop 0
    v_add_f32_dpp v32, v32, v32 quad_perm:[2,3,0,1] row_mask:0xf bank_mask:0xf
    v_add_f32_dpp v33, v33, v33 quad_perm:[2,3,0,1] row_mask:0xf bank_mask:0xf
    s_nop 0
    v_add_f32_dpp v32, v32, v32 row_half_mirror row_mask:0xf bank_mask:0xf
    v_add_f32_dpp v33, v33, v33 row_half_mirror row_mask:0xf bank_mask:0xf
    v_dot2_f32_bf16 v34, v140, v20, 0
    v_dot2_f32_bf16 v35, v152, v20, 0
    v_dot2_f32_bf16 v34, v141, v21, v34
    v_dot2_f32_bf16 v35, v153, v21, v35
    v_dot2_f32_bf16 v34, v142, v22, v34
    v_dot2_f32_bf16 v35, v154, v22, v35
    v_dot2_f32_bf16 v34, v143, v23, v34
    v_dot2_f32_bf16 v35, v155, v23, v35
    v_dot2_f32_bf16 v34, v144, v24, v34
    v_dot2_f32_bf16 v35, v156, v24, v35
    v_dot2_f32_bf16 v34, v145, v25, v34
    v_dot2_f32_bf16 v35, v157, v25, v35
    v_dot2_f32_bf16 v34, v146, v26, v34
    v_dot2_f32_bf16 v35, v158, v26, v35
    v_dot2_f32_bf16 v34, v147, v27, v34
    v_dot2_f32_bf16 v35, v159, v27, v35
    v_dot2_f32_bf16 v34, v148, v28, v34
    v_dot2_f32_bf16 v35, v160, v28, v35
    v_dot2_f32_bf16 v34, v149, v29, v34
    v_dot2_f32_bf16 v35, v161, v29, v35
    v_dot2_f32_bf16 v34, v150, v30, v34
    v_dot2_f32_bf16 v35, v162, v30, v35
    v_dot2_f32_bf16 v34, v151, v31, v34
    v_dot2_f32_bf16 v35, v163, v31, v35
    s_nop 1
    v_add_f32_dpp v34, v34, v34 quad_perm:[1,0,3,2] row_mask:0xf bank_mask:0xf
    v_add_f32_dpp v35, v35, v35 quad_perm:[1,0,3,2] row_mask:0xf bank_mask:0xf
    s_nop 0
    v_add_f32_dpp v34, v34, v34 quad_perm:[2,3,0,1] row_mask:0xf bank_mask:0xf
    v_add_f32_dpp v35, v35, v35 quad_perm:[2,3,0,1] row_mask:0xf bank_mask:0xf
    s_nop 0
    v_add_f32_dpp v34, v34, v34 row_half_mirror row_mask:0xf bank_mask:0xf
    v_add_f32_dpp v35, v35, v35 row_half_mirror row_mask:0xf bank_mask:0xf
    s_waitcnt vmcnt(24)
    s_waitcnt vmcnt(23)
    s_waitcnt vmcnt(22)
    s_waitcnt vmcnt(21)
    s_waitcnt vmcnt(20)
    s_waitcnt vmcnt(19)
    v_dot2_f32_bf16 v36, v96, v20, 0
    v_dot2_f32_bf16 v37, v108, v20, 0
    v_dot2_f32_bf16 v36, v97, v21, v36
    v_dot2_f32_bf16 v37, v109, v21, v37
    v_dot2_f32_bf16 v36, v98, v22, v36
    v_dot2_f32_bf16 v37, v110, v22, v37
    v_dot2_f32_bf16 v36, v99, v23, v36
    v_dot2_f32_bf16 v37, v111, v23, v37
    v_dot2_f32_bf16 v36, v100, v24, v36
    v_dot2_f32_bf16 v37, v112, v24, v37
    v_dot2_f32_bf16 v36, v101, v25, v36
    v_dot2_f32_bf16 v37, v113, v25, v37
    v_dot2_f32_bf16 v36, v102, v26, v36
    v_dot2_f32_bf16 v37, v114, v26, v37
    v_dot2_f32_bf16 v36, v103, v27, v36
    v_dot2_f32_bf16 v37, v115, v27, v37
    v_dot2_f32_bf16 v36, v104, v28, v36
    v_dot2_f32_bf16 v37, v164, v28, v37
    v_dot2_f32_bf16 v36, v105, v29, v36
    v_dot2_f32_bf16 v37, v165, v29, v37
    v_dot2_f32_bf16 v36, v106, v30, v36
    v_dot2_f32_bf16 v37, v166, v30, v37
    v_dot2_f32_bf16 v36, v107, v31, v36
    v_dot2_f32_bf16 v37, v167, v31, v37
    s_nop 1
    v_add_f32_dpp v36, v36, v36 quad_perm:[1,0,3,2] row_mask:0xf bank_mask:0xf
    v_add_f32_dpp v37, v37, v37 quad_perm:[1,0,3,2] row_mask:0xf bank_mask:0xf
    s_nop 0
    v_add_f32_dpp v36, v36, v36 quad_perm:[2,3,0,1] row_mask:0xf bank_mask:0xf
    v_add_f32_dpp v37, v37, v37 quad_perm:[2,3,0,1] row_mask:0xf bank_mask:0xf
    s_nop 0
    v_add_f32_dpp v36, v36, v36 row_half_mirror row_mask:0xf bank_mask:0xf
    v_add_f32_dpp v37, v37, v37 row_half_mirror row_mask:0xf bank_mask:0xf
    s_waitcnt vmcnt(18)
    s_waitcnt vmcnt(17)
    s_waitcnt vmcnt(16)
    s_waitcnt vmcnt(15)
    s_waitcnt vmcnt(14)
    s_waitcnt vmcnt(13)
    v_dot2_f32_bf16 v38, v168, v20, 0
    v_dot2_f32_bf16 v39, v180, v20, 0
    v_dot2_f32_bf16 v38, v169, v21, v38
    v_dot2_f32_bf16 v39, v181, v21, v39
    v_dot2_f32_bf16 v38, v170, v22, v38
    v_dot2_f32_bf16 v39, v182, v22, v39
    v_dot2_f32_bf16 v38, v171, v23, v38
    v_dot2_f32_bf16 v39, v183, v23, v39
    v_dot2_f32_bf16 v38, v172, v24, v38
    v_dot2_f32_bf16 v39, v184, v24, v39
    v_dot2_f32_bf16 v38, v173, v25, v38
    v_dot2_f32_bf16 v39, v185, v25, v39
    v_dot2_f32_bf16 v38, v174, v26, v38
    v_dot2_f32_bf16 v39, v186, v26, v39
    v_dot2_f32_bf16 v38, v175, v27, v38
    v_dot2_f32_bf16 v39, v187, v27, v39
    v_dot2_f32_bf16 v38, v176, v28, v38
    v_dot2_f32_bf16 v39, v188, v28, v39
    v_dot2_f32_bf16 v38, v177, v29, v38
    v_dot2_f32_bf16 v39, v189, v29, v39
    v_dot2_f32_bf16 v38, v178, v30, v38
    v_dot2_f32_bf16 v39, v190, v30, v39
    v_dot2_f32_bf16 v38, v179, v31, v38
    v_dot2_f32_bf16 v39, v191, v31, v39
    s_nop 1
    v_add_f32_dpp v38, v38, v38 quad_perm:[1,0,3,2] row_mask:0xf bank_mask:0xf
    v_add_f32_dpp v39, v39, v39 quad_perm:[1,0,3,2] row_mask:0xf bank_mask:0xf
    s_nop 0
    v_add_f32_dpp v38, v38, v38 quad_perm:[2,3,0,1] row_mask:0xf bank_mask:0xf
    v_add_f32_dpp v39, v39, v39 quad_perm:[2,3,0,1] row_mask:0xf bank_mask:0xf
    s_nop 0
    v_add_f32_dpp v38, v38, v38 row_half_mirror row_mask:0xf bank_mask:0xf
    v_add_f32_dpp v39, v39, v39 row_half_mirror row_mask:0xf bank_mask:0xf
    v_max3_f32 v88, v32, v33, v34
    v_max3_f32 v89, v35, v36, v37
    v_max3_f32 v88, v88, v38, v39
    v_max_f32 v88, v88, v89
    s_nop 1
    v_max_f32_dpp v88, v88, v88 row_ror:8 row_mask:0xf bank_mask:0xf
    s_nop 1
    v_max_f32_dpp v88, v88, v88 row_bcast:15 row_mask:0xa bank_mask:0xf
    s_nop 1
    v_max_f32_dpp v88, v88, v88 row_bcast:31 row_mask:0xc bank_mask:0xf
    s_nop 0
    v_readlane_b32 s26, v88, 63
    s_nop 1
    v_mov_b32 v88, s26
    v_mul_f32 v88, s16, v88
    v_sub_f32 v93, 0, v88
    v_fma_f32 v32, v32, s16, v93
    v_fma_f32 v33, v33, s16, v93
    v_fma_f32 v34, v34, s16, v93
    v_fma_f32 v35, v35, s16, v93
    v_fma_f32 v36, v36, s16, v93
    v_fma_f32 v37, v37, s16, v93
    v_fma_f32 v38, v38, s16, v93
    v_fma_f32 v39, v39, s16, v93
    v_exp_f32 v32, v32
    v_exp_f32 v33, v33
    v_exp_f32 v34, v34
    v_exp_f32 v35, v35
    v_exp_f32 v36, v36
    v_exp_f32 v37, v37
    v_exp_f32 v38, v38
    v_exp_f32 v39, v39
    v_cvt_pk_bf16_f32 v32, v32, v32
    v_cvt_pk_bf16_f32 v33, v33, v33
    v_cvt_pk_bf16_f32 v34, v34, v34
    v_cvt_pk_bf16_f32 v35, v35, v35
    v_cvt_pk_bf16_f32 v36, v36, v36
    v_cvt_pk_bf16_f32 v37, v37, v37
    v_cvt_pk_bf16_f32 v38, v38, v38
    v_cvt_pk_bf16_f32 v39, v39, v39
    v_and_b32 v89, 0xffff0000, v32
    v_and_b32 v93, 0xffff0000, v33
    v_add_f32 v89, v89, v93
    v_and_b32 v93, 0xffff0000, v34
    v_add_f32 v89, v89, v93
    v_and_b32 v93, 0xffff0000, v35
    v_add_f32 v89, v89, v93
    v_and_b32 v93, 0xffff0000, v36
    v_add_f32 v89, v89, v93
    v_and_b32 v93, 0xffff0000, v37
    v_add_f32 v89, v89, v93
    v_and_b32 v93, 0xffff0000, v38
    v_add_f32 v89, v89, v93
    v_and_b32 v93, 0xffff0000, v39
    v_add_f32 v89, v89, v93
    s_nop 1
    v_add_f32_dpp v89, v89, v89 row_ror:8 row_mask:0xf bank_mask:0xf
    s_nop 1
    v_add_f32_dpp v89, v89, v89 row_bcast:15 row_mask:0xa bank_mask:0xf
    s_nop 1
    v_add_f32_dpp v89, v89, v89 row_bcast:31 row_mask:0xc bank_mask:0xf
    s_lshl_b32 s11, s3, 2
    v_mov_b32 v93, s11
    s_mov_b32 exec_lo, 0
    s_mov_b32 exec_hi, 0x80000000
    ds_write_b32 v93, v88 offset:39440
    ds_write_b32 v93, v89 offset:39472
    s_mov_b64 exec, -1
    v_mov_b32_dpp v32, v32 row_shl:4 row_mask:0xf bank_mask:0x2
    v_mov_b32_dpp v33, v33 row_shl:4 row_mask:0xf bank_mask:0x2
    v_mov_b32_dpp v34, v34 row_shl:4 row_mask:0xf bank_mask:0x2
    v_mov_b32_dpp v35, v35 row_shl:4 row_mask:0xf bank_mask:0x2
    v_mov_b32_dpp v36, v36 row_shl:4 row_mask:0xf bank_mask:0x2
    v_mov_b32_dpp v37, v37 row_shl:4 row_mask:0xf bank_mask:0x2
    v_mov_b32_dpp v38, v38 row_shl:4 row_mask:0xf bank_mask:0x2
    v_mov_b32_dpp v39, v39 row_shl:4 row_mask:0xf bank_mask:0x2
    v_and_b32 v40, v32, v7
    v_and_b32 v41, v32, v8
    v_and_b32 v42, v33, v7
    v_and_b32 v43, v33, v8
    v_and_b32 v44, v34, v7
    v_and_b32 v45, v34, v8
    v_and_b32 v46, v35, v7
    v_and_b32 v47, v35, v8
    v_and_b32 v48, v36, v7
    v_and_b32 v49, v36, v8
    v_and_b32 v50, v37, v7
    v_and_b32 v51, v37, v8
    v_and_b32 v52, v38, v7
    v_and_b32 v53, v38, v8
    v_and_b32 v54, v39, v7
    v_and_b32 v55, v39, v8
    s_waitcnt vmcnt(12)
    v_mfma_f32_16x16x16_bf16 v[56:59], v[192:193], v[40:41], 0
    v_mfma_f32_16x16x16_bf16 v[60:63], v[194:195], v[40:41], 0
    s_add_u32 s90, s72, 12288
    buffer_load_dwordx4 v[96:99], v2, s[32:35], s90 offen offset:0 nt
    s_waitcnt vmcnt(12)
    v_mfma_f32_16x16x16_bf16 v[64:67], v[196:197], v[40:41], 0
    v_mfma_f32_16x16x16_bf16 v[68:71], v[198:199], v[40:41], 0
    s_add_u32 s90, s72, 12288
    buffer_load_dwordx4 v[100:103], v2, s[32:35], s90 offen offset:128 nt
    s_waitcnt vmcnt(12)
    v_mfma_f32_16x16x16_bf16 v[72:75], v[200:201], v[40:41], 0
    v_mfma_f32_16x16x16_bf16 v[76:79], v[202:203], v[40:41], 0
    s_add_u32 s90, s72, 12288
    buffer_load_dwordx4 v[104:107], v2, s[32:35], s90 offen offset:256 nt
    s_waitcnt vmcnt(12)
    v_mfma_f32_16x16x16_bf16 v[56:59], v[204:205], v[42:43], v[56:59]
    v_mfma_f32_16x16x16_bf16 v[60:63], v[206:207], v[42:43], v[60:63]
    s_add_u32 s90, s72, 12288
    buffer_load_dwordx4 v[108:111], v2, s[32:35], s90 offen offset:3072 nt
    s_waitcnt vmcnt(12)
    v_mfma_f32_16x16x16_bf16 v[64:67], v[208:209], v[42:43], v[64:67]
    v_mfma_f32_16x16x16_bf16 v[68:71], v[210:211], v[42:43], v[68:71]
    s_add_u32 s90, s72, 12288
    buffer_load_dwordx4 v[112:115], v2, s[32:35], s90 offen offset:3200 nt
    s_waitcnt vmcnt(12)
    v_mfma_f32_16x16x16_bf16 v[72:75], v[212:213], v[42:43], v[72:75]
    v_mfma_f32_16x16x16_bf16 v[76:79], v[214:215], v[42:43], v[76:79]
    s_add_u32 s90, s72, 12288
    buffer_load_dwordx4 v[116:119], v2, s[32:35], s90 offen offset:3328 nt
    s_waitcnt vmcnt(12)
    v_mfma_f32_16x16x16_bf16 v[56:59], v[216:217], v[44:45], v[56:59]
    v_mfma_f32_16x16x16_bf16 v[60:63], v[218:219], v[44:45], v[60:63]
    s_add_u32 s90, s72, 18432
    buffer_load_dwordx4 v[120:123], v2, s[32:35], s90 offen offset:0 nt
    s_waitcnt vmcnt(12)
    v_mfma_f32_16x16x16_bf16 v[64:67], v[220:221], v[44:45], v[64:67]
    v_mfma_f32_16x16x16_bf16 v[68:71], v[222:223], v[44:45], v[68:71]
    s_add_u32 s90, s72, 18432
    buffer_load_dwordx4 v[124:127], v2, s[32:35], s90 offen offset:128 nt
    s_waitcnt vmcnt(12)
    v_mfma_f32_16x16x16_bf16 v[72:75], v[224:225], v[44:45], v[72:75]
    v_mfma_f32_16x16x16_bf16 v[76:79], v[226:227], v[44:45], v[76:79]
    s_add_u32 s90, s72, 18432
    buffer_load_dwordx4 v[128:131], v2, s[32:35], s90 offen offset:256 nt
    s_waitcnt lgkmcnt(0)
    s_barrier
    ds_read_b32 v14, v14
    v_mov_b32 v88, 0
    ds_read_b128 v[20:23], v88 offset:39440
    ds_read_b128 v[24:27], v88 offset:39456
    v_and_b32 v89, 3, v1
    v_lshlrev_b32 v89, 3, v89
    ds_read_b64 v[28:29], v89 offset:39440
    v_and_b32 v89, 7, v1
    v_lshlrev_b32 v89, 2, v89
    ds_read_b32 v30, v89 offset:39440
    ds_read_b32 v31, v89 offset:39472
    s_waitcnt lgkmcnt(0)
    v_max3_f32 v88, v20, v21, v22
    v_max3_f32 v89, v23, v24, v25
    v_max3_f32 v88, v88, v26, v27
    v_max_f32 v20, v88, v89
    v_sub_f32 v15, v28, v20
    v_sub_f32 v16, v29, v20
    v_sub_f32 v88, v30, v20
    v_exp_f32 v15, v15
    v_exp_f32 v16, v16
    v_exp_f32 v88, v88
    s_nop 0
    v_mul_f32 v21, v88, v31
    s_nop 1
    v_add_f32_dpp v21, v21, v21 quad_perm:[1,0,3,2] row_mask:0xf bank_mask:0xf
    s_nop 1
    v_add_f32_dpp v21, v21, v21 quad_perm:[2,3,0,1] row_mask:0xf bank_mask:0xf
    s_nop 1
    v_add_f32_dpp v21, v21, v21 row_half_mirror row_mask:0xf bank_mask:0xf
    v_mov_b32 v22, s95
    v_mov_b32 v23, s95
    v_mov_b32 v88, 0
    s_nop 0
    s_cmp_lg_u32 s3, 3
    s_cbranch_scc1 L_skip_7
    s_mov_b64 exec, 1
    buffer_store_dwordx4 v[20:23], v88, s[64:67], s18 offen sc1
    s_add_u32 s11, s18, 262144
    buffer_store_dwordx4 v[20:23], v88, s[64:67], s11 offen
    s_mov_b64 exec, -1
L_skip_7:
    v_and_b32 v88, 3, v1
    v_mul_u32_u24 v24, 4736, v88
    v_bfe_u32 v89, v1, 4, 1
    v_mul_u32_u24 v92, 384, v89
    v_bfe_u32 v93, v1, 2, 2
    v_lshlrev_b32 v93, 4, v93
    v_add3_u32 v24, v24, v92, v93
    v_lshrrev_b32 v92, 5, v1
    v_lshl_add_u32 v24, v92, 6, v24
    s_mul_i32 s11, s3, 768
    s_add_u32 s11, s11, 17408
    v_add_u32 v24, s11, v24
    v_lshrrev_b32 v25, 4, v1
    v_lshlrev_b32 v25, 8, v25
    v_add_u32 v25, v25, v93
    s_lshl_b32 s79, s3, 10
    s_add_u32 s79, s79, s17
    s_waitcnt vmcnt(12)
    v_mfma_f32_16x16x16_bf16 v[56:59], v[228:229], v[46:47], v[56:59]
    v_mfma_f32_16x16x16_bf16 v[60:63], v[230:231], v[46:47], v[60:63]
    s_add_u32 s90, s72, 18432
    buffer_load_dwordx4 v[132:135], v2, s[32:35], s90 offen offset:3072 nt
    s_waitcnt vmcnt(12)
    v_mfma_f32_16x16x16_bf16 v[64:67], v[232:233], v[46:47], v[64:67]
    v_mfma_f32_16x16x16_bf16 v[68:71], v[234:235], v[46:47], v[68:71]
    s_add_u32 s90, s72, 18432
    buffer_load_dwordx4 v[136:139], v2, s[32:35], s90 offen offset:3200 nt
    s_waitcnt vmcnt(12)
    v_mfma_f32_16x16x16_bf16 v[72:75], v[236:237], v[46:47], v[72:75]
    v_mfma_f32_16x16x16_bf16 v[76:79], v[238:239], v[46:47], v[76:79]
    s_add_u32 s90, s72, 18432
    buffer_load_dwordx4 v[140:143], v2, s[32:35], s90 offen offset:3328 nt
    s_waitcnt vmcnt(11)
    v_mfma_f32_16x16x16_bf16 v[56:59], v[96:97], v[48:49], v[56:59]
    v_mfma_f32_16x16x16_bf16 v[60:63], v[98:99], v[48:49], v[60:63]
    s_waitcnt vmcnt(10)
    v_mfma_f32_16x16x16_bf16 v[64:67], v[100:101], v[48:49], v[64:67]
    v_mfma_f32_16x16x16_bf16 v[68:71], v[102:103], v[48:49], v[68:71]
    s_waitcnt vmcnt(9)
    v_mfma_f32_16x16x16_bf16 v[72:75], v[104:105], v[48:49], v[72:75]
    v_mfma_f32_16x16x16_bf16 v[76:79], v[106:107], v[48:49], v[76:79]
    s_waitcnt vmcnt(8)
    v_mfma_f32_16x16x16_bf16 v[56:59], v[108:109], v[50:51], v[56:59]
    v_mfma_f32_16x16x16_bf16 v[60:63], v[110:111], v[50:51], v[60:63]
    s_waitcnt vmcnt(7)
    v_mfma_f32_16x16x16_bf16 v[64:67], v[112:113], v[50:51], v[64:67]
    v_mfma_f32_16x16x16_bf16 v[68:71], v[114:115], v[50:51], v[68:71]
    s_waitcnt vmcnt(6)
    v_mfma_f32_16x16x16_bf16 v[72:75], v[116:117], v[50:51], v[72:75]
    v_mfma_f32_16x16x16_bf16 v[76:79], v[118:119], v[50:51], v[76:79]
    s_barrier
    s_waitcnt vmcnt(12)
    s_mov_b32 s15, 400000
    s_cmp_ge_u32 s2, 240
    s_cbranch_scc1 L_hok_9
L_hpoll_8:
    v_xor_b32 v88, s94, v17
    v_and_b32 v88, 0xff, v88
    v_cmp_ne_u32 vcc, 0, v88
    s_nop 0
    s_cbranch_vccz L_hok_9
    s_sub_u32 s15, s15, 1
    s_cbranch_scc1 L_hok_9
    s_sleep 4
    buffer_load_dword v17, v10, s[68:71], s21 offen sc1
    s_waitcnt vmcnt(0)
    s_branch L_hpoll_8
L_hok_9:
    v_add_f32_dpp v17, v17, v17 quad_perm:[1,0,3,2] row_mask:0xf bank_mask:0xf
    s_nop 1
    v_add_f32_dpp v17, v17, v17 quad_perm:[2,3,0,1] row_mask:0xf bank_mask:0xf
    v_sub_f32 v88, 1.0, v14
    v_max_f32 v17, 0, v17
    v_mul_f32 v17, v17, v88
    v_cvt_pk_bf16_f32 v17, v17, v17
    v_and_b32 v90, v17, v7
    v_and_b32 v91, v17, v8
    s_add_u32 s85, s22, 262144
    s_add_u32 s86, s24, 262144
    s_waitcnt vmcnt(5)
    v_mfma_f32_16x16x16_bf16 v[56:59], v[120:121], v[52:53], v[56:59]
    v_mfma_f32_16x16x16_bf16 v[60:63], v[122:123], v[52:53], v[60:63]
    s_waitcnt vmcnt(4)
    v_mfma_f32_16x16x16_bf16 v[64:67], v[124:125], v[52:53], v[64:67]
    v_mfma_f32_16x16x16_bf16 v[68:71], v[126:127], v[52:53], v[68:71]
    s_waitcnt vmcnt(3)
    v_mfma_f32_16x16x16_bf16 v[72:75], v[128:129], v[52:53], v[72:75]
    v_mfma_f32_16x16x16_bf16 v[76:79], v[130:131], v[52:53], v[76:79]
    s_waitcnt vmcnt(2)
    v_mfma_f32_16x16x16_bf16 v[56:59], v[132:133], v[54:55], v[56:59]
    v_mfma_f32_16x16x16_bf16 v[60:63], v[134:135], v[54:55], v[60:63]
    s_waitcnt vmcnt(1)
    v_mfma_f32_16x16x16_bf16 v[64:67], v[136:137], v[54:55], v[64:67]
    v_mfma_f32_16x16x16_bf16 v[68:71], v[138:139], v[54:55], v[68:71]
    s_waitcnt vmcnt(0)
    v_mfma_f32_16x16x16_bf16 v[72:75], v[140:141], v[54:55], v[72:75]
    v_mfma_f32_16x16x16_bf16 v[76:79], v[142:143], v[54:55], v[76:79]
    buffer_load_dwordx4 v[104:107], v5, s[44:47], s77 offen nt
    buffer_load_dwordx4 v[108:111], v5, s[40:43], s76 offen nt
    s_add_u32 s90, s76, 10240
    buffer_load_dwordx4 v[112:115], v5, s[40:43], s90 offen nt
    s_add_u32 s90, s76, 20480
    buffer_load_dwordx4 v[116:119], v5, s[40:43], s90 offen nt
    s_add_u32 s90, s76, 30720
    buffer_load_dwordx4 v[120:123], v5, s[40:43], s90 offen nt
    s_mov_b64 exec, s[88:89]
    ds_write_b128 v13, v[56:59] offset:0
    ds_write_b128 v13, v[60:63] offset:384
    ds_write_b128 v13, v[64:67] offset:768
    ds_write_b128 v13, v[68:71] offset:1152
    ds_write_b128 v13, v[72:75] offset:1536
    ds_write_b128 v13, v[76:79] offset:1920
    s_mov_b64 exec, -1
    s_waitcnt lgkmcnt(0)
    s_barrier
    s_cmp_gt_u32 s3, 2
    s_cbranch_scc1 L_noored_10
    ds_read_b128 v[124:127], v24 offset:0
    ds_read_b128 v[128:131], v24 offset:128
    ds_read_b128 v[132:135], v24 offset:2368
    ds_read_b128 v[136:139], v24 offset:2496
    s_waitcnt lgkmcnt(2)
    v_add_f32 v124, v124, v128
    v_add_f32 v125, v125, v129
    v_add_f32 v126, v126, v130
    v_add_f32 v127, v127, v131
    v_mul_f32 v124, v124, v15
    v_mul_f32 v125, v125, v15
    v_mul_f32 v126, v126, v15
    v_mul_f32 v127, v127, v15
    s_waitcnt lgkmcnt(0)
    v_add_f32 v132, v132, v136
    v_add_f32 v133, v133, v137
    v_add_f32 v134, v134, v138
    v_add_f32 v135, v135, v139
    v_fmac_f32 v124, v132, v16
    v_fmac_f32 v125, v133, v16
    v_fmac_f32 v126, v134, v16
    v_fmac_f32 v127, v135, v16
    v_add_f32_dpp v124, v124, v124 quad_perm:[1,0,3,2] row_mask:0xf bank_mask:0xf
    v_add_f32_dpp v125, v125, v125 quad_perm:[1,0,3,2] row_mask:0xf bank_mask:0xf
    v_add_f32_dpp v126, v126, v126 quad_perm:[1,0,3,2] row_mask:0xf bank_mask:0xf
    v_add_f32_dpp v127, v127, v127 quad_perm:[1,0,3,2] row_mask:0xf bank_mask:0xf
    v_add_f32_dpp v124, v124, v124 quad_perm:[2,3,0,1] row_mask:0xf bank_mask:0xf
    v_add_f32_dpp v125, v125, v125 quad_perm:[2,3,0,1] row_mask:0xf bank_mask:0xf
    v_add_f32_dpp v126, v126, v126 quad_perm:[2,3,0,1] row_mask:0xf bank_mask:0xf
    v_add_f32_dpp v127, v127, v127 quad_perm:[2,3,0,1] row_mask:0xf bank_mask:0xf
    v_and_or_b32 v124, v124, v0, s94
    v_and_or_b32 v125, v125, v0, s94
    v_and_or_b32 v126, v126, v0, s94
    v_and_or_b32 v127, v127, v0, s94
    s_mov_b32 exec_lo, 0x11111111
    s_mov_b32 exec_hi, 0x11111111
    s_add_u32 s11, s79, 262144
    buffer_store_dwordx4 v[124:127], v25, s[64:67], s11 offen
    buffer_store_dwordx4 v[124:127], v25, s[64:67], s79 offen sc1
    s_mov_b64 exec, -1
    s_nop 1
L_noored_10:
    s_barrier
    buffer_load_dwordx4 v[96:99], v11, s[68:71], s85 offen sc1
    buffer_load_dwordx4 v[100:103], v6, s[68:71], s86 offen sc1
    v_bfe_u32 v89, v1, 1, 1
    v_lshlrev_b32 v89, 2, v89
    v_bfe_u32 v88, v1, 2, 2
    v_add_u32 v89, v89, v88
    v_mul_u32_u24 v88, 272, v89
    v_lshrrev_b32 v89, 4, v1
    v_lshl_add_u32 v88, v89, 6, v88
    v_and_b32 v89, 1, v1
    v_mul_u32_u24 v92, 8704, v89
    s_lshl_b32 s11, s3, 4
    v_add3_u32 v88, v88, v92, s11
    v_lshrrev_b32 v92, 1, v1
    v_lshlrev_b32 v92, 4, v92
    s_mul_i32 s11, s3, 2560
    s_add_u32 s11, s11, s20
    v_mov_b32 v26, v88
    v_mov_b32 v27, v92
    s_mov_b32 s80, s11
    s_waitcnt vmcnt(6)
    v_mfma_f32_16x16x16_bf16 v[80:83], v[104:105], v[90:91], 0
    v_mfma_f32_16x16x16_bf16 v[84:87], v[106:107], v[90:91], 0
    s_mov_b32 s15, 400000
    s_waitcnt vmcnt(0)
    s_cmp_ge_u32 s2, 240
    s_cbranch_scc1 L_oA_12
L_opoll_11:
    v_xor_b32 v88, s94, v96
    v_xor_b32 v89, s94, v97
    v_xor_b32 v92, s94, v98
    v_or3_b32 v88, v88, v89, v92
    v_xor_b32 v89, s94, v99
    v_or_b32 v88, v88, v89
    v_and_b32 v88, 0xff, v88
    v_cmp_ne_u32 s[96:97], 0, v88
    v_xor_b32 v89, s95, v102
    v_xor_b32 v92, s95, v103
    v_or_b32 v89, v89, v92
    v_cmp_ne_u32 s[98:99], 0, v89
    s_nop 0
    s_or_b64 s[100:101], s[96:97], s[98:99]
    s_cbranch_scc0 L_oA_12
    s_sub_u32 s15, s15, 1
    s_cbranch_scc1 L_oA_12
    s_and_b32 s12, s15, 3
    s_cselect_b32 s12, 262144, 0
    s_add_u32 s85, s22, s12
    s_add_u32 s86, s24, s12
    s_mov_b64 exec, s[96:97]
    s_cbranch_execz L_o1_13
    buffer_load_dwordx4 v[96:99], v11, s[68:71], s85 offen sc1
L_o1_13:
    s_mov_b64 exec, s[98:99]
    s_cbranch_execz L_o2_14
    buffer_load_dwordx4 v[100:103], v6, s[68:71], s86 offen sc1
L_o2_14:
    s_mov_b64 exec, -1
    s_waitcnt vmcnt(0)
    s_branch L_opoll_11
L_oA_12:
    v_max_f32_dpp v88, v100, v100 quad_perm:[1,0,3,2] row_mask:0xf bank_mask:0xf
    v_sub_f32 v88, v100, v88
    v_exp_f32 v88, v88
    s_nop 0
    v_mul_f32 v89, v88, v101
    v_mul_f32 v88, v88, v14
    s_nop 0
    v_add_f32_dpp v89, v89, v89 quad_perm:[1,0,3,2] row_mask:0xf bank_mask:0xf
    v_rcp_f32 v89, v89
    s_nop 0
    v_mul_f32 v88, v88, v89
    v_mul_f32 v32, v96, v88
    v_mul_f32 v33, v97, v88
    v_mul_f32 v34, v98, v88
    v_mul_f32 v35, v99, v88
    v_add_f32_dpp v32, v32, v32 quad_perm:[1,0,3,2] row_mask:0xf bank_mask:0xf
    v_add_f32_dpp v33, v33, v33 quad_perm:[1,0,3,2] row_mask:0xf bank_mask:0xf
    v_add_f32_dpp v34, v34, v34 quad_perm:[1,0,3,2] row_mask:0xf bank_mask:0xf
    v_add_f32_dpp v35, v35, v35 quad_perm:[1,0,3,2] row_mask:0xf bank_mask:0xf
    v_cvt_pk_bf16_f32 v32, v32, v32
    v_cvt_pk_bf16_f32 v33, v33, v33
    v_cvt_pk_bf16_f32 v34, v34, v34
    v_cvt_pk_bf16_f32 v35, v35, v35
    v_and_b32 v40, v32, v7
    v_and_b32 v41, v32, v8
    v_and_b32 v42, v33, v7
    v_and_b32 v43, v33, v8
    v_and_b32 v44, v34, v7
    v_and_b32 v45, v34, v8
    v_and_b32 v46, v35, v7
    v_and_b32 v47, v35, v8
    v_mfma_f32_16x16x16_bf16 v[80:83], v[108:109], v[40:41], v[80:83]
    v_mfma_f32_16x16x16_bf16 v[84:87], v[110:111], v[40:41], v[84:87]
    v_mfma_f32_16x16x16_bf16 v[80:83], v[112:113], v[42:43], v[80:83]
    v_mfma_f32_16x16x16_bf16 v[84:87], v[114:115], v[42:43], v[84:87]
    v_mfma_f32_16x16x16_bf16 v[80:83], v[116:117], v[44:45], v[80:83]
    v_mfma_f32_16x16x16_bf16 v[84:87], v[118:119], v[44:45], v[84:87]
    v_mfma_f32_16x16x16_bf16 v[80:83], v[120:121], v[46:47], v[80:83]
    v_mfma_f32_16x16x16_bf16 v[84:87], v[122:123], v[46:47], v[84:87]
    s_nop 6
    ds_write_b32 v9, v80 offset:0
    ds_write_b32 v9, v81 offset:272
    ds_write_b32 v9, v82 offset:544
    ds_write_b32 v9, v83 offset:816
    ds_write_b32 v9, v84 offset:1088
    ds_write_b32 v9, v85 offset:1360
    ds_write_b32 v9, v86 offset:1632
    ds_write_b32 v9, v87 offset:1904
    s_waitcnt lgkmcnt(0)
    s_barrier
    s_cmp_gt_u32 s3, 3
    s_cbranch_scc1 L_noy_15
    v_mov_b32 v88, v26
    v_mov_b32 v92, v27
    s_mov_b32 s11, s80
    ds_read_b128 v[124:127], v88 offset:0
    ds_read_b128 v[128:131], v88 offset:2176
    ds_read_b128 v[132:135], v88 offset:4352
    ds_read_b128 v[136:139], v88 offset:6528
    s_waitcnt lgkmcnt(2)
    v_add_f32 v124, v124, v128
    v_add_f32 v125, v125, v129
    v_add_f32 v126, v126, v130
    v_add_f32 v127, v127, v131
    s_waitcnt lgkmcnt(0)
    v_add_f32 v132, v132, v136
    v_add_f32 v133, v133, v137
    v_add_f32 v134, v134, v138
    v_add_f32 v135, v135, v139
    v_add_f32 v124, v124, v132
    v_add_f32 v125, v125, v133
    v_add_f32 v126, v126, v134
    v_add_f32 v127, v127, v135
    v_add_f32_dpp v124, v124, v124 quad_perm:[1,0,3,2] row_mask:0xf bank_mask:0xf
    v_add_f32_dpp v125, v125, v125 quad_perm:[1,0,3,2] row_mask:0xf bank_mask:0xf
    v_add_f32_dpp v126, v126, v126 quad_perm:[1,0,3,2] row_mask:0xf bank_mask:0xf
    v_add_f32_dpp v127, v127, v127 quad_perm:[1,0,3,2] row_mask:0xf bank_mask:0xf
    v_and_or_b32 v124, v124, v0, s94
    v_and_or_b32 v125, v125, v0, s94
    v_and_or_b32 v126, v126, v0, s94
    v_and_or_b32 v127, v127, v0, s94
    s_mov_b32 exec_lo, 0x55555555
    s_mov_b32 exec_hi, 0x55555555
    buffer_store_dwordx4 v[124:127], v92, s[68:71], s11 offen sc1
    s_mov_b64 exec, -1
    s_branch L_fin
L_noy_15:
    s_nop 0
    s_cmp_lg_u32 s3, 4
    s_cbranch_scc1 L_fin
    s_cmp_lt_u32 s2, 96
    s_cbranch_scc1 L_fin
    s_sub_u32 s11, s2, 96
    s_mul_i32 s12, s11, 205
    s_lshr_b32 s12, s12, 13
    s_mul_i32 s13, s12, 40
    s_sub_u32 s13, s11, s13
    s_mul_i32 s14, s12, 2560
    s_lshl_b32 s11, s13, 6
    s_add_u32 s14, s14, s11
    s_add_u32 s81, s14, 1441792
    s_add_u32 s82, s81, 163840
    s_add_u32 s83, s81, 327680
    s_mul_i32 s12, s12, 1280
    s_lshl_b32 s11, s13, 5
    s_add_u32 s12, s12, s11
    v_lshrrev_b32 v20, 2, v1
    v_mul_u32_u24 v20, 10240, v20
    v_and_b32 v89, 3, v1
    v_lshl_add_u32 v20, v89, 4, v20
    v_lshlrev_b32 v21, 3, v89
    v_bfe_u32 v92, v1, 4, 1
    v_lshl_add_u32 v21, v92, 2, v21
    v_lshrrev_b32 v92, 5, v1
    v_lshl_add_u32 v21, v92, 1, v21
    s_mov_b32 s15, 400000
    s_waitcnt vmcnt(0)
    buffer_load_dwordx4 v[56:59], v20, s[64:67], s81 offen sc1
    buffer_load_dwordx4 v[60:63], v20, s[64:67], s82 offen sc1
    buffer_load_dwordx4 v[64:67], v20, s[64:67], s83 offen sc1
L_ypoll_16:
    s_waitcnt vmcnt(0)
    v_xor_b32 v88, s94, v56
    v_xor_b32 v89, s94, v57
    v_xor_b32 v92, s94, v58
    v_or3_b32 v88, v88, v89, v92
    v_xor_b32 v89, s94, v59
    v_or_b32 v88, v88, v89
    v_and_b32 v88, 0xff, v88
    v_cmp_ne_u32 s[96:97], 0, v88
    v_xor_b32 v88, s94, v60
    v_xor_b32 v89, s94, v61
    v_xor_b32 v92, s94, v62
    v_or3_b32 v88, v88, v89, v92
    v_xor_b32 v89, s94, v63
    v_or_b32 v88, v88, v89
    v_and_b32 v88, 0xff, v88
    v_cmp_ne_u32 s[98:99], 0, v88
    v_xor_b32 v88, s94, v64
    v_xor_b32 v89, s94, v65
    v_xor_b32 v92, s94, v66
    v_or3_b32 v88, v88, v89, v92
    v_xor_b32 v89, s94, v67
    v_or_b32 v88, v88, v89
    v_and_b32 v88, 0xff, v88
    v_cmp_ne_u32 s[100:101], 0, v88
    s_or_b64 vcc, s[96:97], s[98:99]
    s_or_b64 vcc, vcc, s[100:101]
    s_cbranch_scc0 L_yA_17
    s_sub_u32 s15, s15, 1
    s_cbranch_scc1 L_yA_17
    s_mov_b64 exec, s[96:97]
    s_cbranch_execz L_yl_18
    buffer_load_dwordx4 v[56:59], v20, s[64:67], s81 offen sc1
L_yl_18:
    s_mov_b64 exec, s[98:99]
    s_cbranch_execz L_yl_19
    buffer_load_dwordx4 v[60:63], v20, s[64:67], s82 offen sc1
L_yl_19:
    s_mov_b64 exec, s[100:101]
    s_cbranch_execz L_yl_20
    buffer_load_dwordx4 v[64:67], v20, s[64:67], s83 offen sc1
L_yl_20:
    s_mov_b64 exec, -1
    s_branch L_ypoll_16
L_yA_17:
    v_add_f32 v40, v56, v60
    v_add_f32 v41, v57, v61
    v_add_f32 v42, v58, v62
    v_add_f32 v43, v59, v63
    v_add_f32 v40, v40, v64
    v_add_f32 v41, v41, v65
    v_add_f32 v42, v42, v66
    v_add_f32 v43, v43, v67
    v_permlane32_swap_b32 v40, v41
    s_nop 0
    v_permlane32_swap_b32 v42, v43
    v_add_f32 v40, v40, v41
    v_add_f32 v42, v42, v43
    s_nop 1
    v_permlane16_swap_b32 v40, v42
    v_add_f32 v40, v40, v42
    s_nop 1
    v_add_f32_dpp v40, v40, v40 row_ror:8 row_mask:0xf bank_mask:0xf
    s_nop 1
    v_add_f32_dpp v40, v40, v40 row_ror:4 row_mask:0xf bank_mask:0xf
    v_cvt_pk_bf16_f32 v40, v40, v40
    s_mov_b32 exec_lo, 0x000f000f
    s_mov_b32 exec_hi, 0x000f000f
    buffer_store_short v40, v21, s[56:59], s12 offen
    s_cmp_lg_u32 s2, 96
    s_cbranch_scc1 L_noep
    v_mov_b32 v88, s95
    v_mov_b32 v89, 520192
    s_mov_b64 exec, 1
    buffer_store_dword v88, v89, s[64:67], 0 offen
L_noep:
    s_mov_b64 exec, -1
L_fin:
L_end:
    s_endpgm
.section .rodata,"a"
.p2align 6
.amdhsa_kernel gated_mix__sliding_block_cached__dense_activation_relu__decode_kernel
  .amdhsa_next_free_vgpr 256
  .amdhsa_next_free_sgpr 102
  .amdhsa_accum_offset 256
  .amdhsa_group_segment_fixed_size 0
  .amdhsa_kernarg_size 96
  .amdhsa_user_sgpr_count 2
  .amdhsa_user_sgpr_kernarg_segment_ptr 1
  .amdhsa_system_sgpr_workgroup_id_x 1
.end_amdhsa_kernel
```
